```python
import torch

def _softmax(x, axis=-1):
    return torch.softmax(x, dim=axis)
def _gelu(x):
    return torch.nn.functional.gelu(x, approximate="tanh")
def _silu(x):
    return torch.nn.functional.silu(x)
def _sigmoid(x):
    return torch.sigmoid(x)
def _layernorm(x, axis=-1, eps=1e-5):
    m = x.mean(dim=axis, keepdim=True)
    v = x.var(dim=axis, keepdim=True, unbiased=False)
    return (x - m) / torch.sqrt(v + eps)
def _scatter_add(tgt, idx, src, axis=0):
    return tgt.clone().index_add_(axis, idx, src)
def _segment_sum(src, seg, n):
    out = torch.zeros((n,) + src.shape[1:], dtype=src.dtype)
    return out.index_add_(0, seg, src)
def _pad(x, pw):
    flat = tuple(v for pair in reversed(pw) for v in pair)
    return torch.nn.functional.pad(x, flat)

kernel_name = 'standalone__channel_attn_eca__vision'

def setup_inputs():

    _w = (lambda a: (lambda t: t.to(torch.bfloat16) if t.is_floating_point() else t)(torch.as_tensor(a)))
    H = W = 384
    C = 96
    k = 3
    return {
        "x": _w((lambda *s: torch.randn(*s, dtype=torch.bfloat16) * 0.2)(1, H, W, C) + (lambda *s: torch.randn(*s, dtype=torch.bfloat16) * 0.2)(1, 1, 1, C) * 2.0),
        "w1d": _w((lambda *s: torch.randn(*s, dtype=torch.bfloat16) * 0.4)(k)),
    }

def reference(x, w1d):
    B, H, W, C = x.shape
    k = 3
    pad = k // 2
    g = torch.einsum("bhwc->bc", x) / (H * W)
    gp = _pad(g, ((0, 0), (pad, pad)))
    s = torch.zeros_like(g)
    for i in range(k):
        s = s + gp[:, i:i + C] * w1d[i]
    s = _sigmoid(s)
    return x * s[:, None, None, :]
```

```asm
; @launch grid=(256,1,1) block=(1024,1,1) lds=10752
.amdgcn_target "amdgcn-amd-amdhsa--gfx950"
.text
.globl standalone__channel_attn_eca__vision_kernel
.p2align 8
.type standalone__channel_attn_eca__vision_kernel,@function
standalone__channel_attn_eca__vision_kernel:
  s_cmp_ge_u32 s2, 256
  s_cbranch_scc1 L_end
  s_load_dwordx4 s[4:7], s[0:1], 0
  s_load_dwordx4 s[8:11], s[0:1], 16
  s_load_dwordx2 s[12:13], s[0:1], 32
  v_lshrrev_b32 v2, 6, v0
  v_and_b32 v3, 63, v0
  v_readfirstlane_b32 s14, v2
  v_mul_u32_u24 v0, 12, v3
  s_and_b32 s3, s2, 7
  s_lshl_b32 s3, s3, 5
  s_lshr_b32 s15, s2, 3
  s_add_u32 s3, s3, s15
  s_lshl_b32 s3, s3, 2
  s_and_b32 s15, s14, 3
  s_add_u32 s3, s3, s15
  s_mul_i32 s3, s3, 768
  s_lshr_b32 s15, s14, 2
  s_mul_i32 s15, s15, 7077888
  s_add_u32 s3, s3, s15
  v_add_u32 v1, s3, v0
  s_getreg_b32 s31, hwreg(HW_REG_XCC_ID, 0, 3)
  s_sub_u32 s28, s2, 32
  s_sub_u32 s29, s14, 12
  s_lshr_b32 s18, s28, 5
  s_lshr_b32 s19, s29, 2
  s_or_b32 s18, s18, s19
  s_cmp_lg_u32 s18, 0
  s_waitcnt lgkmcnt(0)
  s_cbranch_scc1 L_noprobe
  s_load_dword s15, s[12:13], 212992
  s_lshl_b32 s28, s28, 2
  s_add_u32 s28, s28, s29
  s_lshr_b32 s18, s28, 3
  s_lshl_b32 s18, s18, 7
  s_and_b32 s19, s28, 1
  s_lshl_b32 s19, s19, 13
  s_add_u32 s18, s18, s19
  s_and_b32 s19, s28, 2
  s_lshl_b32 s19, s19, 11
  s_add_u32 s18, s18, s19
  s_and_b32 s19, s28, 4
  s_lshl_b32 s19, s19, 12
  s_add_u32 s18, s18, s19
  s_add_u32 s18, s18, 229376
  s_lshr_b32 s19, s28, 2
  s_lshl_b32 s19, s19, 7
  s_lshl_b32 s29, s29, 2
  s_add_u32 s29, s29, s19
  s_add_u32 s29, s29, 217088
  s_waitcnt lgkmcnt(0)
  s_memtime s[20:21]
  s_waitcnt lgkmcnt(0)
  s_load_dword s19, s[12:13], s18
  s_waitcnt lgkmcnt(0)
  s_memtime s[22:23]
  s_add_u32 s15, s15, 1
  s_and_b32 s15, s15, 15
  s_lshr_b32 s19, s31, 2
  s_lshl_b32 s19, s19, 4
  s_or_b32 s15, s15, s19
  v_mov_b32 v102, s29
  s_waitcnt lgkmcnt(0)
  s_sub_u32 s18, s22, s20
  s_min_u32 s18, s18, 0xfffff
  s_lshl_b32 s18, s18, 5
  s_or_b32 s18, s18, s15
  v_mov_b32 v103, s18
  s_mov_b64 exec, 1
  s_setprio 3
  global_store_dword v102, v103, s[12:13] sc1
  s_setprio 0
  s_mov_b64 exec, -1
L_noprobe:
  global_load_dwordx3 v[4:6], v1, s[4:5] nt
  s_add_u32 s4, s4, 786432
  s_addc_u32 s5, s5, 0
  s_load_dword s15, s[12:13], 212992
  s_load_dwordx2 s[16:17], s[6:7], 0
  global_load_dwordx3 v[8:10], v1, s[4:5] nt
  s_add_u32 s4, s4, 786432
  s_addc_u32 s5, s5, 0
  global_load_dwordx3 v[12:14], v1, s[4:5] nt
  s_add_u32 s4, s4, 786432
  s_addc_u32 s5, s5, 0
  global_load_dwordx3 v[16:18], v1, s[4:5] nt
  s_add_u32 s4, s4, 786432
  s_addc_u32 s5, s5, 0
  global_load_dwordx3 v[20:22], v1, s[4:5] nt
  s_add_u32 s4, s4, 786432
  s_addc_u32 s5, s5, 0
  global_load_dwordx3 v[24:26], v1, s[4:5] nt
  s_add_u32 s4, s4, 786432
  s_addc_u32 s5, s5, 0
  global_load_dwordx3 v[28:30], v1, s[4:5] nt
  s_add_u32 s4, s4, 786432
  s_addc_u32 s5, s5, 0
  global_load_dwordx3 v[32:34], v1, s[4:5] nt
  s_add_u32 s4, s4, 786432
  s_addc_u32 s5, s5, 0
  global_load_dwordx3 v[36:38], v1, s[4:5] nt
  v_mov_b32 v7, 0
  v_mov_b32 v11, 0
  v_mov_b32 v15, 0
  v_mov_b32 v19, 0
  v_mov_b32 v23, 0
  v_mov_b32 v27, 0
  v_mov_b32 v31, 0
  v_mov_b32 v35, 0
  v_mov_b32 v39, 0
  v_and_b32 v102, 15, v3
  v_lshrrev_b32 v103, 2, v102
  v_sub_u32 v103, v102, v103
  v_and_b32 v104, 3, v102
  v_cmp_ne_u32 s[18:19], 3, v104
  v_cmp_gt_u32 s[20:21], 8, v102
  v_and_b32 v104, 1, v103
  v_lshlrev_b32 v104, 4, v104
  s_and_b64 s[18:19], s[18:19], s[20:21]
  v_mov_b32 v105, 0x3f80
  v_lshlrev_b32 v104, v104, v105
  v_lshrrev_b32 v103, 1, v103
  v_cndmask_b32 v104, 0, v104, s[18:19]
  v_cmp_eq_u32 s[18:19], 0, v103
  v_cmp_eq_u32 s[20:21], 1, v103
  v_cmp_eq_u32 s[22:23], 2, v103
  v_mov_b32 v97, 0
  v_cndmask_b32 v94, 0, v104, s[18:19]
  v_cndmask_b32 v95, 0, v104, s[20:21]
  v_cndmask_b32 v96, 0, v104, s[22:23]
  v_mul_u32_u24 v123, v102, v102
  v_mul_u32_u24 v123, 11, v123
  v_bfe_u32 v123, v123, 3, 4
  v_lshrrev_b32 v103, 4, v3
  v_lshlrev_b32 v103, 4, v103
  v_lshl_add_u32 v103, v102, 5, v103
  s_lshl_b32 s26, s14, 9
  v_add_u32 v103, s26, v103
  s_mov_b32 s25, 0xffff0000
  v_lshlrev_b32 v3, 2, v3
  s_mov_b32 s24, 1048576
  s_lshl_b32 s18, s14, 8
  v_add_u32 v118, s18, v3
  v_mul_u32_u24 v2, 171, v118
  v_lshrrev_b32 v2, 11, v2
  v_lshl_add_u32 v2, v2, 2, v118
  v_and_b32 v119, 0x7c, v118
  v_lshrrev_b32 v118, 7, v118
  v_lshlrev_b32 v118, 14, v118
  s_lshr_b32 s18, s2, 6
  s_mul_i32 s18, s18, 49152
  s_and_b32 s19, s2, 63
  s_lshl_b32 s19, s19, 7
  s_add_u32 s18, s18, s19
  v_add3_u32 v118, v118, v119, s18
  s_sub_u32 s28, s2, 16
  s_lshl_b32 s20, s28, 14
  s_lshl_b32 s21, s14, 9
  s_add_u32 s20, s20, s21
  v_add_u32 v119, s20, v3
  s_lshl_b32 s21, s14, 7
  v_add_u32 v120, s21, v3
  s_lshl_b32 s29, s28, 7
  s_add_u32 s29, s29, 196608
  s_waitcnt vmcnt(8)
  v_mfma_f32_16x16x32_bf16 v[98:101], v[94:97], v[4:7], 0
  s_waitcnt vmcnt(7)
  v_mfma_f32_16x16x32_bf16 v[98:101], v[94:97], v[8:11], v[98:101]
  s_waitcnt vmcnt(6)
  v_mfma_f32_16x16x32_bf16 v[98:101], v[94:97], v[12:15], v[98:101]
  s_waitcnt vmcnt(5)
  v_mfma_f32_16x16x32_bf16 v[98:101], v[94:97], v[16:19], v[98:101]
  s_waitcnt vmcnt(4)
  v_mfma_f32_16x16x32_bf16 v[98:101], v[94:97], v[20:23], v[98:101]
  s_waitcnt vmcnt(3)
  v_mfma_f32_16x16x32_bf16 v[98:101], v[94:97], v[24:27], v[98:101]
  s_waitcnt vmcnt(2)
  v_mfma_f32_16x16x32_bf16 v[98:101], v[94:97], v[28:31], v[98:101]
  s_waitcnt vmcnt(1)
  v_mfma_f32_16x16x32_bf16 v[98:101], v[94:97], v[32:35], v[98:101]
  s_waitcnt vmcnt(0)
  v_mfma_f32_16x16x32_bf16 v[98:101], v[94:97], v[36:39], v[98:101]
  s_waitcnt lgkmcnt(0)
  s_add_u32 s15, s15, 1
  s_and_b32 s27, s15, 15
  v_xor_b32 v123, s27, v123
  s_nop 2
  s_mov_b32 exec_hi, 0
  ds_write_b128 v103, v[98:101] offset:0
  s_mov_b32 exec_hi, -1
  s_cmp_lg_u32 s14, 11
  s_cbranch_scc1 L_nocount
  v_and_b32 v104, 4, v3
  v_sub_u32 v122, v3, v104
  v_lshlrev_b32 v122, 4, v122
  v_lshl_add_u32 v122, v104, 1, v122
  v_add_u32 v122, 217088, v122
  global_load_dwordx2 v[106:107], v122, s[12:13] sc1
  s_lshr_b32 s19, s31, 2
  v_mov_b32 v105, 10624
  s_waitcnt vmcnt(0)
  v_xor_b32 v121, s27, v106
  v_xor_b32 v122, s27, v107
  v_or_b32 v104, v121, v122
  v_and_b32 v104, 15, v104
  v_cmp_eq_u32 s[20:21], 0, v104
  v_cmp_lt_u32 vcc, v122, v121
  v_and_b32 v104, 16, v121
  v_cmp_ne_u32 s[22:23], 0, v104
  s_xor_b64 vcc, vcc, s[22:23]
  s_and_b64 vcc, vcc, s[20:21]
  s_bcnt1_i32_b64 s18, vcc
  s_bcnt1_i32_b64 s20, s[20:21]
  s_lshl_b32 s18, s18, 1
  s_cmp_gt_u32 s18, s20
  s_cselect_b32 s18, 1, 0
  s_xor_b32 s18, s18, s19
  s_lshl_b32 s18, s18, 13
  v_mov_b32 v104, s18
  s_mov_b64 exec, -1
  ds_write_b32 v105, v104
L_nocount:
  v_mov_b32 v121, 10624
  s_waitcnt lgkmcnt(0)
  s_barrier
  s_cmp_ge_u32 s14, 2
  s_cbranch_scc1 L_nopub
  s_setprio 3
  ds_read2st64_b32 v[94:95], v2 offset0:0 offset1:2
  ds_read2st64_b32 v[96:97], v2 offset0:4 offset1:6
  ds_read2st64_b32 v[98:99], v2 offset0:8 offset1:10
  ds_read2st64_b32 v[100:101], v2 offset0:12 offset1:14
  ds_read2st64_b32 v[102:103], v2 offset0:16 offset1:18
  ds_read2st64_b32 v[104:105], v2 offset0:20 offset1:22
  ds_read2st64_b32 v[106:107], v2 offset0:24 offset1:26
  ds_read2st64_b32 v[108:109], v2 offset0:28 offset1:30
  s_cmp_eq_u32 s14, 0
  s_cselect_b32 s18, 0x11111111, 0
  v_xor_b32 v122, 0x2000, v118
  s_waitcnt lgkmcnt(6)
  v_pk_add_f32 v[94:95], v[94:95], v[96:97]
  s_waitcnt lgkmcnt(4)
  v_pk_add_f32 v[98:99], v[98:99], v[100:101]
  v_pk_add_f32 v[94:95], v[94:95], v[98:99]
  s_waitcnt lgkmcnt(2)
  v_pk_add_f32 v[102:103], v[102:103], v[104:105]
  s_waitcnt lgkmcnt(0)
  v_pk_add_f32 v[106:107], v[106:107], v[108:109]
  v_pk_add_f32 v[102:103], v[102:103], v[106:107]
  v_pk_add_f32 v[94:95], v[94:95], v[102:103]
  v_add_f32 v94, v94, v95
  v_and_or_b32 v94, v94, -16, v123
  s_nop 1
  v_mov_b32_dpp v95, v94 quad_perm:[1,1,1,1] row_mask:0xf bank_mask:0xf
  v_mov_b32_dpp v96, v94 quad_perm:[2,2,2,2] row_mask:0xf bank_mask:0xf
  v_mov_b32_dpp v97, v94 quad_perm:[3,3,3,3] row_mask:0xf bank_mask:0xf
  s_mov_b32 exec_lo, 0x11111111
  s_mov_b32 exec_hi, s18
  global_store_dwordx4 v118, v[94:97], s[12:13] sc1
  global_store_dwordx4 v122, v[94:97], s[12:13] sc1
  s_mov_b64 exec, -1
L_nopub:
  ds_read_b32 v121, v121 offset:0
  s_cmp_ge_u32 s28, 12
  s_cbranch_scc1 L_notown
  s_waitcnt lgkmcnt(0)
  v_add_u32 v119, v119, v121
  global_load_dword v110, v119, s[12:13] offset:0 sc1
  global_load_dword v111, v119, s[12:13] offset:256 sc1
L_own:
  global_load_dword v112, v119, s[12:13] offset:0 sc1
  global_load_dword v113, v119, s[12:13] offset:256 sc1
  s_waitcnt vmcnt(3)
  v_xor_b32 v110, v123, v110
  s_waitcnt vmcnt(2)
  v_xor_b32 v111, v123, v111
  v_or_b32 v7, v110, v111
  v_add_f32 v94, v110, v111
  v_and_b32 v7, 15, v7
  v_cmp_ne_u32 vcc, 0, v7
  v_mov_b32 v95, v94
  s_sub_u32 s24, s24, 1
  s_cbranch_scc1 L_own_ok
  s_cbranch_vccz L_own_ok
  global_load_dword v110, v119, s[12:13] offset:0 sc1
  global_load_dword v111, v119, s[12:13] offset:256 sc1
  s_waitcnt vmcnt(3)
  v_xor_b32 v112, v123, v112
  s_waitcnt vmcnt(2)
  v_xor_b32 v113, v123, v113
  v_or_b32 v7, v112, v113
  v_add_f32 v94, v112, v113
  v_and_b32 v7, 15, v7
  v_cmp_ne_u32 vcc, 0, v7
  v_mov_b32 v95, v94
  s_sub_u32 s24, s24, 1
  s_cbranch_scc1 L_own_ok
  s_cbranch_vccz L_own_ok
  s_branch L_own
L_own_ok:
  v_permlane32_swap_b32 v94, v95
  s_mov_b32 exec_hi, 0
  v_add_f32 v94, v94, v95
  ds_write_b32 v120, v94 offset:8192
  s_mov_b32 exec_hi, -1
  s_movk_i32 s18, 8192
  v_and_b32 v119, 0x80, v3
  v_mul_u32_u24 v119, 7, v119
  v_add3_u32 v119, v119, v3, s18
  v_lshrrev_b32 v120, 7, v3
  v_mul_u32_u24 v120, 1408, v120
  v_add3_u32 v120, v120, v3, s29
  s_waitcnt lgkmcnt(0)
  s_barrier
  s_cmp_lg_u32 s14, 0
  s_cbranch_scc1 L_notown
  ds_read2_b32 v[94:95], v119 offset0:0 offset1:32
  ds_read2_b32 v[96:97], v119 offset0:64 offset1:96
  ds_read2_b32 v[98:99], v119 offset0:128 offset1:160
  ds_read2_b32 v[100:101], v119 offset0:192 offset1:224
  v_add_u32 v122, 0x2000, v120
  s_waitcnt lgkmcnt(2)
  v_pk_add_f32 v[94:95], v[94:95], v[96:97]
  s_waitcnt lgkmcnt(0)
  v_pk_add_f32 v[98:99], v[98:99], v[100:101]
  v_pk_add_f32 v[94:95], v[94:95], v[98:99]
  v_add_f32 v94, v94, v95
  v_mov_b32 v95, v94
  s_nop 1
  v_permlane32_swap_b32 v94, v95
  v_add_f32 v94, v94, v95
  v_and_or_b32 v94, v94, -16, v123
  s_nop 1
  v_mov_b32_dpp v95, v94 quad_perm:[1,1,1,1] row_mask:0xf bank_mask:0xf
  v_mov_b32_dpp v96, v94 quad_perm:[2,2,2,2] row_mask:0xf bank_mask:0xf
  v_mov_b32_dpp v97, v94 quad_perm:[3,3,3,3] row_mask:0xf bank_mask:0xf
  s_mov_b32 exec_lo, 0x11111111
  s_mov_b32 exec_hi, 0x11111111
  global_store_dwordx4 v120, v[94:97], s[12:13] sc1
  global_store_dwordx4 v122, v[94:97], s[12:13] sc1
  global_store_dwordx4 v120, v[94:97], s[12:13] offset:3072 sc1
  global_store_dwordx4 v122, v[94:97], s[12:13] offset:3072 sc1
  s_mov_b64 exec, -1
L_notown:
  v_lshlrev_b32 v40, 16, v4
  v_and_b32 v41, s25, v4
  v_lshlrev_b32 v42, 16, v5
  v_and_b32 v43, s25, v5
  v_lshlrev_b32 v44, 16, v6
  v_and_b32 v45, s25, v6
  v_lshlrev_b32 v46, 16, v8
  v_and_b32 v47, s25, v8
  v_lshlrev_b32 v48, 16, v9
  v_and_b32 v49, s25, v9
  v_lshlrev_b32 v50, 16, v10
  v_and_b32 v51, s25, v10
  v_lshlrev_b32 v52, 16, v12
  v_and_b32 v53, s25, v12
  v_lshlrev_b32 v54, 16, v13
  v_and_b32 v55, s25, v13
  v_lshlrev_b32 v56, 16, v14
  v_and_b32 v57, s25, v14
  v_lshlrev_b32 v58, 16, v16
  v_and_b32 v59, s25, v16
  v_lshlrev_b32 v60, 16, v17
  v_and_b32 v61, s25, v17
  v_lshlrev_b32 v62, 16, v18
  v_and_b32 v63, s25, v18
  v_lshlrev_b32 v64, 16, v20
  v_and_b32 v65, s25, v20
  v_lshlrev_b32 v66, 16, v21
  v_and_b32 v67, s25, v21
  v_lshlrev_b32 v68, 16, v22
  v_and_b32 v69, s25, v22
  v_lshlrev_b32 v70, 16, v24
  v_and_b32 v71, s25, v24
  v_lshlrev_b32 v72, 16, v25
  v_and_b32 v73, s25, v25
  v_lshlrev_b32 v74, 16, v26
  v_and_b32 v75, s25, v26
  v_lshlrev_b32 v76, 16, v28
  v_and_b32 v77, s25, v28
  v_lshlrev_b32 v78, 16, v29
  v_and_b32 v79, s25, v29
  v_lshlrev_b32 v80, 16, v30
  v_and_b32 v81, s25, v30
  v_lshlrev_b32 v82, 16, v32
  v_and_b32 v83, s25, v32
  v_lshlrev_b32 v84, 16, v33
  v_and_b32 v85, s25, v33
  v_lshlrev_b32 v86, 16, v34
  v_and_b32 v87, s25, v34
  v_lshlrev_b32 v88, 16, v36
  v_and_b32 v89, s25, v36
  v_lshlrev_b32 v90, 16, v37
  v_and_b32 v91, s25, v37
  v_lshlrev_b32 v92, 16, v38
  v_and_b32 v93, s25, v38
  s_cmp_ge_u32 s14, 2
  s_cbranch_scc1 L_wait
  s_and_b32 s31, s31, 3
  s_mul_i32 s31, s31, 1536
  s_lshl_b32 s22, s14, 7
  s_add_u32 s23, s22, 196608
  s_add_u32 s23, s23, s31
  s_waitcnt lgkmcnt(0)
  v_add3_u32 v119, v121, v3, s23
  s_add_u32 s23, s22, 10240
  v_add_u32 v120, s23, v3
  s_lshl_b32 s18, s16, 16
  s_and_b32 s19, s16, 0xffff0000
  s_lshl_b32 s20, s17, 16
  s_mov_b32 s21, 0x36e38e39
  s_cmp_eq_u32 s14, 0
  s_cselect_b32 s22, -1, 0xffff0000
  s_cselect_b32 s23, 0xffff, -1
  s_mov_b32 s30, 1048576
L_poll:
  global_load_dword v114, v119, s[12:13] offset:0 sc1
  global_load_dword v115, v119, s[12:13] offset:384 sc1
  global_load_dword v116, v119, s[12:13] offset:768 sc1
  global_load_dword v117, v119, s[12:13] offset:1152 sc1
  s_waitcnt vmcnt(3)
  v_xor_b32 v114, v123, v114
  s_waitcnt vmcnt(2)
  v_xor_b32 v115, v123, v115
  v_or_b32 v7, v114, v115
  v_add_f32 v94, v114, v115
  s_waitcnt vmcnt(1)
  v_xor_b32 v116, v123, v116
  v_or_b32 v7, v7, v116
  v_add_f32 v94, v94, v116
  s_waitcnt vmcnt(0)
  v_xor_b32 v117, v123, v117
  v_or_b32 v7, v7, v117
  v_add_f32 v94, v94, v117
  v_and_b32 v7, 15, v7
  v_cmp_ne_u32 vcc, 0, v7
  s_sub_u32 s30, s30, 1
  s_cbranch_scc1 L_poll_ok
  s_cbranch_vccz L_poll_ok
  s_branch L_poll
L_poll_ok:
  v_cvt_pk_bf16_f32 v94, 0, v94
  v_mul_f32 v94, s21, v94
  v_cvt_pk_bf16_f32 v94, 0, v94
  v_mul_f32 v96, s18, v94
  v_mul_f32 v98, s20, v94
  v_mul_f32 v97, s19, v94
  v_cvt_pk_bf16_f32 v96, 0, v96
  v_cvt_pk_bf16_f32 v98, 0, v98
  v_cvt_pk_bf16_f32 v97, 0, v97
  v_add_f32_dpp v94, v96, v97 wave_shr:1 row_mask:0xf bank_mask:0xf bound_ctrl:0
  v_cvt_pk_bf16_f32 v94, 0, v94
  v_add_f32_dpp v94, v98, v94 wave_shl:1 row_mask:0xf bank_mask:0xf bound_ctrl:0
  v_cvt_pk_bf16_f32 v94, 0, v94
  v_mul_f32 v94, 0xbfb8aa3b, v94
  v_exp_f32 v94, v94
  s_nop 0
  v_add_f32 v94, 1.0, v94
  v_rcp_f32 v94, v94
  s_nop 0
  v_cvt_pk_bf16_f32 v94, 0, v94
  s_mov_b64 exec, s[22:23]
  ds_write_b32 v120, v94
  s_setprio 0
  s_or_b32 s18, s2, s14
  s_cmp_lg_u32 s18, 0
  s_cbranch_scc1 L_noepo
  s_mov_b64 exec, 1
  v_mov_b32 v119, 212992
  v_mov_b32 v122, s15
  global_store_dword v119, v122, s[12:13] sc1
L_noepo:
  s_mov_b64 exec, -1
L_wait:
  v_and_b32 v3, 60, v3
  v_mul_u32_u24 v3, 6, v3
  s_waitcnt lgkmcnt(0)
  s_barrier
  ds_read_b64 v[102:103], v3 offset:10240
  ds_read_b64 v[104:105], v3 offset:10248
  ds_read_b64 v[106:107], v3 offset:10256
  s_waitcnt lgkmcnt(0)
  v_pk_mul_f32 v[40:41], v[40:41], v[102:103]
  v_pk_mul_f32 v[42:43], v[42:43], v[104:105]
  v_pk_mul_f32 v[44:45], v[44:45], v[106:107]
  v_cvt_pk_bf16_f32 v4, v40, v41
  v_cvt_pk_bf16_f32 v5, v42, v43
  v_cvt_pk_bf16_f32 v6, v44, v45
  global_store_dwordx3 v1, v[4:6], s[8:9] sc1
  s_add_u32 s8, s8, 786432
  s_addc_u32 s9, s9, 0
  v_pk_mul_f32 v[46:47], v[46:47], v[102:103]
  v_pk_mul_f32 v[48:49], v[48:49], v[104:105]
  v_pk_mul_f32 v[50:51], v[50:51], v[106:107]
  v_cvt_pk_bf16_f32 v8, v46, v47
  v_cvt_pk_bf16_f32 v9, v48, v49
  v_cvt_pk_bf16_f32 v10, v50, v51
  global_store_dwordx3 v1, v[8:10], s[8:9] sc1
  s_add_u32 s8, s8, 786432
  s_addc_u32 s9, s9, 0
  v_pk_mul_f32 v[52:53], v[52:53], v[102:103]
  v_pk_mul_f32 v[54:55], v[54:55], v[104:105]
  v_pk_mul_f32 v[56:57], v[56:57], v[106:107]
  v_cvt_pk_bf16_f32 v12, v52, v53
  v_cvt_pk_bf16_f32 v13, v54, v55
  v_cvt_pk_bf16_f32 v14, v56, v57
  global_store_dwordx3 v1, v[12:14], s[8:9] sc1
  s_add_u32 s8, s8, 786432
  s_addc_u32 s9, s9, 0
  v_pk_mul_f32 v[58:59], v[58:59], v[102:103]
  v_pk_mul_f32 v[60:61], v[60:61], v[104:105]
  v_pk_mul_f32 v[62:63], v[62:63], v[106:107]
  v_cvt_pk_bf16_f32 v16, v58, v59
  v_cvt_pk_bf16_f32 v17, v60, v61
  v_cvt_pk_bf16_f32 v18, v62, v63
  global_store_dwordx3 v1, v[16:18], s[8:9] sc1
  s_add_u32 s8, s8, 786432
  s_addc_u32 s9, s9, 0
  v_pk_mul_f32 v[64:65], v[64:65], v[102:103]
  v_pk_mul_f32 v[66:67], v[66:67], v[104:105]
  v_pk_mul_f32 v[68:69], v[68:69], v[106:107]
  v_cvt_pk_bf16_f32 v20, v64, v65
  v_cvt_pk_bf16_f32 v21, v66, v67
  v_cvt_pk_bf16_f32 v22, v68, v69
  global_store_dwordx3 v1, v[20:22], s[8:9] sc1
  s_add_u32 s8, s8, 786432
  s_addc_u32 s9, s9, 0
  v_pk_mul_f32 v[70:71], v[70:71], v[102:103]
  v_pk_mul_f32 v[72:73], v[72:73], v[104:105]
  v_pk_mul_f32 v[74:75], v[74:75], v[106:107]
  v_cvt_pk_bf16_f32 v24, v70, v71
  v_cvt_pk_bf16_f32 v25, v72, v73
  v_cvt_pk_bf16_f32 v26, v74, v75
  global_store_dwordx3 v1, v[24:26], s[8:9] sc1
  s_add_u32 s8, s8, 786432
  s_addc_u32 s9, s9, 0
  v_pk_mul_f32 v[76:77], v[76:77], v[102:103]
  v_pk_mul_f32 v[78:79], v[78:79], v[104:105]
  v_pk_mul_f32 v[80:81], v[80:81], v[106:107]
  v_cvt_pk_bf16_f32 v28, v76, v77
  v_cvt_pk_bf16_f32 v29, v78, v79
  v_cvt_pk_bf16_f32 v30, v80, v81
  global_store_dwordx3 v1, v[28:30], s[8:9] sc1
  s_add_u32 s8, s8, 786432
  s_addc_u32 s9, s9, 0
  v_pk_mul_f32 v[82:83], v[82:83], v[102:103]
  v_pk_mul_f32 v[84:85], v[84:85], v[104:105]
  v_pk_mul_f32 v[86:87], v[86:87], v[106:107]
  v_cvt_pk_bf16_f32 v32, v82, v83
  v_cvt_pk_bf16_f32 v33, v84, v85
  v_cvt_pk_bf16_f32 v34, v86, v87
  global_store_dwordx3 v1, v[32:34], s[8:9] sc1
  s_add_u32 s8, s8, 786432
  s_addc_u32 s9, s9, 0
  v_pk_mul_f32 v[88:89], v[88:89], v[102:103]
  v_pk_mul_f32 v[90:91], v[90:91], v[104:105]
  v_pk_mul_f32 v[92:93], v[92:93], v[106:107]
  v_cvt_pk_bf16_f32 v36, v88, v89
  v_cvt_pk_bf16_f32 v37, v90, v91
  v_cvt_pk_bf16_f32 v38, v92, v93
  global_store_dwordx3 v1, v[36:38], s[8:9] sc1
L_end:
  s_endpgm
.section .rodata,"a"
.p2align 6
.amdhsa_kernel standalone__channel_attn_eca__vision_kernel
  .amdhsa_next_free_vgpr 128
  .amdhsa_next_free_sgpr 32
  .amdhsa_accum_offset 128
  .amdhsa_group_segment_fixed_size 0
  .amdhsa_kernarg_size 40
  .amdhsa_user_sgpr_count 2
  .amdhsa_user_sgpr_kernarg_segment_ptr 1
  .amdhsa_system_sgpr_workgroup_id_x 1
  .amdhsa_float_denorm_mode_32 3
.end_amdhsa_kernel
```
